```python
import torch

def _softmax(x, axis=-1):
    return torch.softmax(x, dim=axis)

def _gelu(x):
    return torch.nn.functional.gelu(x, approximate='tanh')

def _silu(x):
    return torch.nn.functional.silu(x)

def _sigmoid(x):
    return torch.sigmoid(x)

def _layernorm(x, axis=-1, eps=1e-05):
    m = x.mean(dim=axis, keepdim=True)
    v = x.var(dim=axis, keepdim=True, unbiased=False)
    return (x - m) / torch.sqrt(v + eps)

def _scatter_add(tgt, idx, src, axis=0):
    return tgt.clone().index_add_(axis, idx, src)

def _segment_sum(src, seg, n):
    out = torch.zeros((n,) + src.shape[1:], dtype=src.dtype)
    return out.index_add_(0, seg, src)

def _pad(x, pw):
    flat = tuple((v for pair in reversed(pw) for v in pair))
    return torch.nn.functional.pad(x, flat)
kernel_name = 'standalone__tree_speculative_verify_tree_attention_over_candidate_token_tree__sampling'

def setup_inputs():

    _w = lambda a: (lambda t: t.to(torch.bfloat16) if t.is_floating_point() else t)(torch.as_tensor(a))
    B, Hq, Hkv, T, C, D = (32, 32, 8, 1, 2048, 128)
    tree_mask = torch.zeros((B, T, T), dtype=float)
    for b in range(B):
        parent = torch.zeros(T, dtype=torch.int64)
        for i in range(1, T):
            parent[i] = int(torch.randint(0, i, (1,)).item())
        for i in range(T):
            j = i
            tree_mask[b, i, j] = 1.0
            while j > 0:
                j = parent[j]
                tree_mask[b, i, j] = 1.0
    return {'q': _w((lambda *s: torch.randn(*s, dtype=torch.bfloat16) * 0.8)(B, Hq, T, D)), 'k_cache': _w((lambda *s: torch.randn(*s, dtype=torch.bfloat16) * 0.8)(B, Hkv, C, D)), 'v_cache': _w((lambda *s: torch.randn(*s, dtype=torch.bfloat16) * 0.05)(B, Hkv, C, D)), 'k_tree': _w((lambda *s: torch.randn(*s, dtype=torch.bfloat16) * 0.8)(B, Hkv, T, D)), 'v_tree': _w((lambda *s: torch.randn(*s, dtype=torch.bfloat16) * 0.05)(B, Hkv, T, D)), 'tree_mask': _w(tree_mask)}

def reference(q, k_cache, v_cache, k_tree, v_tree, tree_mask):
    B, Hq, T, D = q.shape
    Hkv, C = (k_cache.shape[1], k_cache.shape[2])
    rep = Hq // Hkv
    kc = (lambda x, n, axis: torch.repeat_interleave(x, n, dim=axis))(k_cache, rep, axis=1)
    vc = (lambda x, n, axis: torch.repeat_interleave(x, n, dim=axis))(v_cache, rep, axis=1)
    kt = (lambda x, n, axis: torch.repeat_interleave(x, n, dim=axis))(k_tree, rep, axis=1)
    vt = (lambda x, n, axis: torch.repeat_interleave(x, n, dim=axis))(v_tree, rep, axis=1)
    k = torch.concatenate([kc, kt], axis=2)
    v = torch.concatenate([vc, vt], axis=2)
    scale = D ** (-0.5)
    scores = torch.einsum('bhqd,bhkd->bhqk', q, k) * scale
    ctx_mask = torch.ones((B, 1, T, C), dtype=scores.dtype)
    tm = tree_mask[:, None, :, :].clone()
    full_mask = torch.concatenate([ctx_mask, tm], axis=-1)
    scores = scores + (1.0 - full_mask) * -1000000000.0
    p = _softmax(scores, axis=-1)
    return torch.einsum('bhqk,bhkd->bhqd', p, v)
```

```asm
; @launch grid=(256,1,1) block=(320,1,1) lds=90000
.amdgcn_target "amdgcn-amd-amdhsa--gfx950"
.text
.globl standalone__tree_speculative_verify_tree_attention_over_candidate_token_tree__sampling_kernel
.p2align 8
.type standalone__tree_speculative_verify_tree_attention_over_candidate_token_tree__sampling_kernel,@function
standalone__tree_speculative_verify_tree_attention_over_candidate_token_tree__sampling_kernel:
    s_load_dwordx16 s[4:19], s[0:1], 0
    s_memrealtime s[60:61]
    v_lshrrev_b32 v8, 6, v0
    v_and_b32 v1, 63, v0
    v_readfirstlane_b32 s20, v8
    s_cmp_ge_u32 s2, 256
    s_cbranch_scc1 L_end
    v_lshlrev_b32 v3, 4, v1
    v_and_b32 v8, 12, v1
    v_lshlrev_b32 v8, 6, v8
    s_cmp_eq_u32 s20, 4
    s_cbranch_scc1 L_helper
    s_mov_b32 s31, s2
    s_and_b32 s3, s2, 7
    s_lshl_b32 s3, s3, 2
    s_bfe_u32 s21, s2, 0x20003
    s_or_b32 s3, s3, s21
    s_and_b32 s2, s2, 0xe0
    s_or_b32 s2, s2, s3
    v_and_b32 v9, 48, v1
    v_lshlrev_b32 v9, 2, v9
    v_and_b32 v10, 48, v3
    v_or3_b32 v2, v8, v9, v10
    s_lshl_b32 s57, s20, 12
    s_bitcmp1_b32 s2, 0
    s_cselect_b32 s56, 0x40400, 0
    s_bitcmp1_b32 s2, 1
    s_cselect_b32 s3, 0x20000, 0
    s_xor_b32 s56, s56, s3
    s_lshl_b32 s3, s2, 19
    s_add_u32 s3, s3, s57
    s_sub_u32 s34, 0x80000, s57
    s_mov_b32 s35, 0x20000
    s_mov_b32 s38, s34
    s_mov_b32 s39, 0x20000
    s_mov_b32 s42, 1024
    s_mov_b32 s43, 0x20000
    s_lshl_b32 s57, s2, 10
    s_waitcnt lgkmcnt(0)
    s_add_u32 s32, s6, s3
    s_addc_u32 s33, s7, 0
    s_add_u32 s40, s4, s57
    s_addc_u32 s41, s5, 0
    buffer_load_dwordx4 v[12:15], v2, s[40:43], 0 offen
    s_mov_b32 s19, 0
    s_mov_b32 s18, s56
    buffer_load_dwordx4 v[80:83], v2, s[32:35], s18 offen offset:0 nt
    s_xor_b32 s21, s18, 0x8000
    buffer_load_dwordx4 v[84:87], v2, s[32:35], s21 offen offset:0 nt
    s_xor_b32 s21, s18, 0x400
    buffer_load_dwordx4 v[88:91], v2, s[32:35], s21 offen offset:0 nt
    s_xor_b32 s21, s18, 0x8400
    buffer_load_dwordx4 v[92:95], v2, s[32:35], s21 offen offset:0 nt
    buffer_load_dwordx4 v[96:99], v2, s[32:35], s18 offen offset:2048 nt
    s_xor_b32 s21, s18, 0x8000
    buffer_load_dwordx4 v[100:103], v2, s[32:35], s21 offen offset:2048 nt
    s_add_u32 s36, s8, s3
    s_addc_u32 s37, s9, 0
    s_add_u32 s52, s16, s57
    s_addc_u32 s53, s17, 0
    s_mov_b32 s54, 1024
    s_mov_b32 s55, 0x20000
    s_lshl_b32 s57, s2, 8
    s_add_u32 s44, s10, s57
    s_addc_u32 s45, s11, 0
    s_mov_b32 s46, 256
    s_mov_b32 s47, 0x20000
    s_add_u32 s48, s12, s57
    s_addc_u32 s49, s13, 0
    s_mov_b32 s50, 256
    s_mov_b32 s51, 0x20000
    s_lshr_b32 s57, s2, 4
    s_lshl_b32 s57, s57, 2
    s_load_dword s23, s[14:15], s57
    s_mov_b32 s22, 0x3e0293ee
    s_mov_b32 s24, 0x22222222
    s_mov_b32 s25, 0x22222222
    s_mov_b32 s26, 0x44444444
    s_mov_b32 s27, 0x44444444
    s_mov_b32 s28, 0x88888888
    s_mov_b32 s29, 0x88888888
    v_mov_b32 v8, 0xffff
    v_mov_b32 v9, 0xffff0000
    v_cndmask_b32 v4, v8, v9, s[24:25]
    v_cndmask_b32 v4, v4, 0, s[26:27]
    v_cndmask_b32 v4, v4, 0, s[28:29]
    v_cndmask_b32 v5, 0, v8, s[26:27]
    v_cndmask_b32 v5, v5, v9, s[28:29]
    v_mov_b32 v28, 0
    v_mov_b32 v29, 0
    v_mov_b32 v30, 0
    v_mov_b32 v31, 0
    v_mov_b32 v32, 0
    v_mov_b32 v33, 0
    v_mov_b32 v34, 0
    v_mov_b32 v35, 0
    v_mov_b32 v6, 0xff7fffff
    v_mov_b32 v7, 0
    s_mul_i32 s57, s20, 8192
    v_lshlrev_b32 v52, 3, v1
    v_add_u32 v52, s57, v52
    v_mov_b32 v0, 0
    v_mov_b32 v53, 0
    v_mov_b32 v58, -1
    s_mov_b32 s62, 0
    s_mov_b32 s64, 0
    s_mov_b32 s63, 0
    s_mov_b32 m0, 0
    s_bfe_u32 s31, s31, 0x10003
    s_add_u32 s31, s31, 1
    s_getreg_b32 s65, hwreg(HW_REG_XCC_ID, 0, 1)
    s_cmp_eq_u32 s65, 0
    s_cselect_b32 s65, 3, 0
    s_barrier
    s_xor_b32 s21, s18, 0x400
    s_waitcnt vmcnt(5)
    buffer_load_dwordx4 v[104:107], v2, s[32:35], s21 offen offset:2048 nt
    s_mov_b32 s30, 15
L_k_disp:
    s_sub_u32 s30, s30, 1
    s_cbranch_scc1 L_k_last
    s_waitcnt lgkmcnt(0)
    v_readfirstlane_b32 s58, v58
    v_readfirstlane_b32 s59, v59
    s_add_u32 s57, s60, s64
    v_writelane_b32 v53, s57, m0
    s_sub_i32 s62, s62, s65
    s_cmp_lg_u32 s20, s31
    s_cbranch_scc1 L_k_nopub
    s_or_b32 s57, s60, 1
    v_mov_b32 v8, s57
    s_lshl_b32 s57, m0, 2
    v_mov_b32 v9, s57
    ds_write_b32 v9, v8 offset:41216
L_k_nopub:
    ds_read_b64 v[58:59], v0 offset:41472
    s_memrealtime s[60:61]
    s_mov_b32 s64, s62
    s_add_u32 m0, m0, 1
    s_cmp_lt_i32 s58, 0
    s_cbranch_scc1 L_k_pick
    v_readlane_b32 s57, v53, s58
    s_add_i32 s63, s62, 200
    s_sub_i32 s57, s57, s59
    s_cmp_ge_u32 s58, m0
    s_cselect_b32 s63, s63, s57
L_k_pick:
    s_sub_i32 s57, s63, s62
    s_cmp_gt_i32 s57, 40
    s_cbranch_scc1 L_k_m3
    s_cmp_gt_i32 s57, 10
    s_cbranch_scc1 L_k_m2
    s_cmp_lt_i32 s57, -35
    s_cbranch_scc1 L_k_m0
L_k_m1:
    s_xor_b32 s21, s18, 0x8400
    s_waitcnt vmcnt(4)
    buffer_load_dwordx4 v[108:111], v2, s[32:35], s21 offen offset:2048 nt
    v_mfma_f32_16x16x32_bf16 v[36:39], v[80:83], v[12:15], 0
    s_add_u32 s19, s19, 1
    s_bfe_u32 s18, s19, 0x20000
    s_lshl_b32 s18, s18, 16
    s_bfe_u32 s21, s19, 0x10002
    s_lshl_b32 s21, s21, 14
    s_or_b32 s18, s18, s21
    s_bfe_u32 s21, s19, 0x10003
    s_lshl_b32 s21, s21, 18
    s_or_b32 s18, s18, s21
    s_xor_b32 s18, s18, s56
    s_waitcnt vmcnt(4)
    buffer_load_dwordx4 v[80:83], v2, s[32:35], s18 offen offset:0 nt
    v_mfma_f32_16x16x32_bf16 v[40:43], v[84:87], v[12:15], 0
    s_xor_b32 s21, s18, 0x8000
    s_waitcnt vmcnt(4)
    buffer_load_dwordx4 v[84:87], v2, s[32:35], s21 offen offset:0 nt
    v_mfma_f32_16x16x32_bf16 v[44:47], v[88:91], v[12:15], 0
    s_xor_b32 s21, s18, 0x400
    s_waitcnt vmcnt(4)
    buffer_load_dwordx4 v[88:91], v2, s[32:35], s21 offen offset:0 nt
    v_mfma_f32_16x16x32_bf16 v[48:51], v[92:95], v[12:15], 0
    s_nop 7
    v_cndmask_b32 v8, v36, v41, s[24:25]
    v_cndmask_b32 v9, v40, v45, s[24:25]
    v_cndmask_b32 v10, v44, v49, s[24:25]
    v_cndmask_b32 v11, v48, v37, s[24:25]
    v_cndmask_b32 v8, v8, v46, s[26:27]
    v_cndmask_b32 v9, v9, v50, s[26:27]
    v_cndmask_b32 v10, v10, v38, s[26:27]
    v_cndmask_b32 v11, v11, v42, s[26:27]
    v_cndmask_b32 v10, v10, v43, s[28:29]
    v_cndmask_b32 v11, v11, v47, s[28:29]
    v_cndmask_b32 v8, v8, v51, s[28:29]
    v_cndmask_b32 v9, v9, v39, s[28:29]
    v_add_f32_dpp v10, v11, v10 quad_perm:[3,0,1,2] row_mask:0xf bank_mask:0xf
    s_nop 0
    v_add_f32_dpp v8, v9, v8 quad_perm:[3,0,1,2] row_mask:0xf bank_mask:0xf
    s_nop 1
    v_add_f32_dpp v54, v10, v8 quad_perm:[2,3,0,1] row_mask:0xf bank_mask:0xf
    v_max_f32 v6, v6, v54
    s_xor_b32 s21, s18, 0x8400
    s_waitcnt vmcnt(4)
    buffer_load_dwordx4 v[92:95], v2, s[32:35], s21 offen offset:0 nt
    v_mfma_f32_16x16x32_bf16 v[36:39], v[96:99], v[12:15], 0
    s_waitcnt vmcnt(4)
    buffer_load_dwordx4 v[96:99], v2, s[32:35], s18 offen offset:2048 nt
    v_mfma_f32_16x16x32_bf16 v[40:43], v[100:103], v[12:15], 0
    s_xor_b32 s21, s18, 0x8000
    s_waitcnt vmcnt(4)
    buffer_load_dwordx4 v[100:103], v2, s[32:35], s21 offen offset:2048 nt
    v_mfma_f32_16x16x32_bf16 v[44:47], v[104:107], v[12:15], 0
    s_xor_b32 s21, s18, 0x400
    s_waitcnt vmcnt(4)
    buffer_load_dwordx4 v[104:107], v2, s[32:35], s21 offen offset:2048 nt
    v_mfma_f32_16x16x32_bf16 v[48:51], v[108:111], v[12:15], 0
    s_nop 7
    v_cndmask_b32 v8, v36, v41, s[24:25]
    v_cndmask_b32 v9, v40, v45, s[24:25]
    v_cndmask_b32 v10, v44, v49, s[24:25]
    v_cndmask_b32 v11, v48, v37, s[24:25]
    v_cndmask_b32 v8, v8, v46, s[26:27]
    v_cndmask_b32 v9, v9, v50, s[26:27]
    v_cndmask_b32 v10, v10, v38, s[26:27]
    v_cndmask_b32 v11, v11, v42, s[26:27]
    v_cndmask_b32 v10, v10, v43, s[28:29]
    v_cndmask_b32 v11, v11, v47, s[28:29]
    v_cndmask_b32 v8, v8, v51, s[28:29]
    v_cndmask_b32 v9, v9, v39, s[28:29]
    v_add_f32_dpp v10, v11, v10 quad_perm:[3,0,1,2] row_mask:0xf bank_mask:0xf
    s_nop 0
    v_add_f32_dpp v8, v9, v8 quad_perm:[3,0,1,2] row_mask:0xf bank_mask:0xf
    s_nop 1
    v_add_f32_dpp v55, v10, v8 quad_perm:[2,3,0,1] row_mask:0xf bank_mask:0xf
    v_max_f32 v6, v6, v55
    ds_write_b64 v52, v[54:55]
    v_add_u32 v52, 512, v52
    s_branch L_k_disp
L_k_m0:
    s_add_i32 s62, s62, -28
    s_xor_b32 s21, s18, 0x8400
    s_waitcnt vmcnt(3)
    buffer_load_dwordx4 v[108:111], v2, s[32:35], s21 offen offset:2048 nt
    v_mfma_f32_16x16x32_bf16 v[36:39], v[80:83], v[12:15], 0
    s_add_u32 s19, s19, 1
    s_bfe_u32 s18, s19, 0x20000
    s_lshl_b32 s18, s18, 16
    s_bfe_u32 s21, s19, 0x10002
    s_lshl_b32 s21, s21, 14
    s_or_b32 s18, s18, s21
    s_bfe_u32 s21, s19, 0x10003
    s_lshl_b32 s21, s21, 18
    s_or_b32 s18, s18, s21
    s_xor_b32 s18, s18, s56
    s_waitcnt vmcnt(3)
    buffer_load_dwordx4 v[80:83], v2, s[32:35], s18 offen offset:0 nt
    v_mfma_f32_16x16x32_bf16 v[40:43], v[84:87], v[12:15], 0
    s_xor_b32 s21, s18, 0x8000
    s_waitcnt vmcnt(3)
    buffer_load_dwordx4 v[84:87], v2, s[32:35], s21 offen offset:0 nt
    v_mfma_f32_16x16x32_bf16 v[44:47], v[88:91], v[12:15], 0
    s_xor_b32 s21, s18, 0x400
    s_waitcnt vmcnt(3)
    buffer_load_dwordx4 v[88:91], v2, s[32:35], s21 offen offset:0 nt
    v_mfma_f32_16x16x32_bf16 v[48:51], v[92:95], v[12:15], 0
    s_nop 7
    v_cndmask_b32 v8, v36, v41, s[24:25]
    v_cndmask_b32 v9, v40, v45, s[24:25]
    v_cndmask_b32 v10, v44, v49, s[24:25]
    v_cndmask_b32 v11, v48, v37, s[24:25]
    v_cndmask_b32 v8, v8, v46, s[26:27]
    v_cndmask_b32 v9, v9, v50, s[26:27]
    v_cndmask_b32 v10, v10, v38, s[26:27]
    v_cndmask_b32 v11, v11, v42, s[26:27]
    v_cndmask_b32 v10, v10, v43, s[28:29]
    v_cndmask_b32 v11, v11, v47, s[28:29]
    v_cndmask_b32 v8, v8, v51, s[28:29]
    v_cndmask_b32 v9, v9, v39, s[28:29]
    v_add_f32_dpp v10, v11, v10 quad_perm:[3,0,1,2] row_mask:0xf bank_mask:0xf
    s_nop 0
    v_add_f32_dpp v8, v9, v8 quad_perm:[3,0,1,2] row_mask:0xf bank_mask:0xf
    s_nop 1
    v_add_f32_dpp v54, v10, v8 quad_perm:[2,3,0,1] row_mask:0xf bank_mask:0xf
    v_max_f32 v6, v6, v54
    s_xor_b32 s21, s18, 0x8400
    s_waitcnt vmcnt(3)
    buffer_load_dwordx4 v[92:95], v2, s[32:35], s21 offen offset:0 nt
    v_mfma_f32_16x16x32_bf16 v[36:39], v[96:99], v[12:15], 0
    s_waitcnt vmcnt(3)
    buffer_load_dwordx4 v[96:99], v2, s[32:35], s18 offen offset:2048 nt
    v_mfma_f32_16x16x32_bf16 v[40:43], v[100:103], v[12:15], 0
    s_xor_b32 s21, s18, 0x8000
    s_waitcnt vmcnt(3)
    buffer_load_dwordx4 v[100:103], v2, s[32:35], s21 offen offset:2048 nt
    v_mfma_f32_16x16x32_bf16 v[44:47], v[104:107], v[12:15], 0
    s_xor_b32 s21, s18, 0x400
    s_waitcnt vmcnt(3)
    buffer_load_dwordx4 v[104:107], v2, s[32:35], s21 offen offset:2048 nt
    v_mfma_f32_16x16x32_bf16 v[48:51], v[108:111], v[12:15], 0
    s_nop 7
    v_cndmask_b32 v8, v36, v41, s[24:25]
    v_cndmask_b32 v9, v40, v45, s[24:25]
    v_cndmask_b32 v10, v44, v49, s[24:25]
    v_cndmask_b32 v11, v48, v37, s[24:25]
    v_cndmask_b32 v8, v8, v46, s[26:27]
    v_cndmask_b32 v9, v9, v50, s[26:27]
    v_cndmask_b32 v10, v10, v38, s[26:27]
    v_cndmask_b32 v11, v11, v42, s[26:27]
    v_cndmask_b32 v10, v10, v43, s[28:29]
    v_cndmask_b32 v11, v11, v47, s[28:29]
    v_cndmask_b32 v8, v8, v51, s[28:29]
    v_cndmask_b32 v9, v9, v39, s[28:29]
    v_add_f32_dpp v10, v11, v10 quad_perm:[3,0,1,2] row_mask:0xf bank_mask:0xf
    s_nop 0
    v_add_f32_dpp v8, v9, v8 quad_perm:[3,0,1,2] row_mask:0xf bank_mask:0xf
    s_nop 1
    v_add_f32_dpp v55, v10, v8 quad_perm:[2,3,0,1] row_mask:0xf bank_mask:0xf
    v_max_f32 v6, v6, v55
    ds_write_b64 v52, v[54:55]
    v_add_u32 v52, 512, v52
    s_branch L_k_disp
L_k_m2:
    s_add_i32 s62, s62, 19
    s_xor_b32 s21, s18, 0x8400
    s_waitcnt vmcnt(5)
    buffer_load_dwordx4 v[108:111], v2, s[32:35], s21 offen offset:2048 nt
    v_mfma_f32_16x16x32_bf16 v[36:39], v[80:83], v[12:15], 0
    s_add_u32 s19, s19, 1
    s_bfe_u32 s18, s19, 0x20000
    s_lshl_b32 s18, s18, 16
    s_bfe_u32 s21, s19, 0x10002
    s_lshl_b32 s21, s21, 14
    s_or_b32 s18, s18, s21
    s_bfe_u32 s21, s19, 0x10003
    s_lshl_b32 s21, s21, 18
    s_or_b32 s18, s18, s21
    s_xor_b32 s18, s18, s56
    s_waitcnt vmcnt(5)
    buffer_load_dwordx4 v[80:83], v2, s[32:35], s18 offen offset:0 nt
    v_mfma_f32_16x16x32_bf16 v[40:43], v[84:87], v[12:15], 0
    s_xor_b32 s21, s18, 0x8000
    s_waitcnt vmcnt(5)
    buffer_load_dwordx4 v[84:87], v2, s[32:35], s21 offen offset:0 nt
    v_mfma_f32_16x16x32_bf16 v[44:47], v[88:91], v[12:15], 0
    s_xor_b32 s21, s18, 0x400
    s_waitcnt vmcnt(5)
    buffer_load_dwordx4 v[88:91], v2, s[32:35], s21 offen offset:0 nt
    v_mfma_f32_16x16x32_bf16 v[48:51], v[92:95], v[12:15], 0
    s_nop 7
    v_cndmask_b32 v8, v36, v41, s[24:25]
    v_cndmask_b32 v9, v40, v45, s[24:25]
    v_cndmask_b32 v10, v44, v49, s[24:25]
    v_cndmask_b32 v11, v48, v37, s[24:25]
    v_cndmask_b32 v8, v8, v46, s[26:27]
    v_cndmask_b32 v9, v9, v50, s[26:27]
    v_cndmask_b32 v10, v10, v38, s[26:27]
    v_cndmask_b32 v11, v11, v42, s[26:27]
    v_cndmask_b32 v10, v10, v43, s[28:29]
    v_cndmask_b32 v11, v11, v47, s[28:29]
    v_cndmask_b32 v8, v8, v51, s[28:29]
    v_cndmask_b32 v9, v9, v39, s[28:29]
    v_add_f32_dpp v10, v11, v10 quad_perm:[3,0,1,2] row_mask:0xf bank_mask:0xf
    s_nop 0
    v_add_f32_dpp v8, v9, v8 quad_perm:[3,0,1,2] row_mask:0xf bank_mask:0xf
    s_nop 1
    v_add_f32_dpp v54, v10, v8 quad_perm:[2,3,0,1] row_mask:0xf bank_mask:0xf
    v_max_f32 v6, v6, v54
    s_xor_b32 s21, s18, 0x8400
    s_waitcnt vmcnt(5)
    buffer_load_dwordx4 v[92:95], v2, s[32:35], s21 offen offset:0 nt
    v_mfma_f32_16x16x32_bf16 v[36:39], v[96:99], v[12:15], 0
    s_waitcnt vmcnt(5)
    buffer_load_dwordx4 v[96:99], v2, s[32:35], s18 offen offset:2048 nt
    v_mfma_f32_16x16x32_bf16 v[40:43], v[100:103], v[12:15], 0
    s_xor_b32 s21, s18, 0x8000
    s_waitcnt vmcnt(5)
    buffer_load_dwordx4 v[100:103], v2, s[32:35], s21 offen offset:2048 nt
    v_mfma_f32_16x16x32_bf16 v[44:47], v[104:107], v[12:15], 0
    s_xor_b32 s21, s18, 0x400
    s_waitcnt vmcnt(5)
    buffer_load_dwordx4 v[104:107], v2, s[32:35], s21 offen offset:2048 nt
    v_mfma_f32_16x16x32_bf16 v[48:51], v[108:111], v[12:15], 0
    s_nop 7
    v_cndmask_b32 v8, v36, v41, s[24:25]
    v_cndmask_b32 v9, v40, v45, s[24:25]
    v_cndmask_b32 v10, v44, v49, s[24:25]
    v_cndmask_b32 v11, v48, v37, s[24:25]
    v_cndmask_b32 v8, v8, v46, s[26:27]
    v_cndmask_b32 v9, v9, v50, s[26:27]
    v_cndmask_b32 v10, v10, v38, s[26:27]
    v_cndmask_b32 v11, v11, v42, s[26:27]
    v_cndmask_b32 v10, v10, v43, s[28:29]
    v_cndmask_b32 v11, v11, v47, s[28:29]
    v_cndmask_b32 v8, v8, v51, s[28:29]
    v_cndmask_b32 v9, v9, v39, s[28:29]
    v_add_f32_dpp v10, v11, v10 quad_perm:[3,0,1,2] row_mask:0xf bank_mask:0xf
    s_nop 0
    v_add_f32_dpp v8, v9, v8 quad_perm:[3,0,1,2] row_mask:0xf bank_mask:0xf
    s_nop 1
    v_add_f32_dpp v55, v10, v8 quad_perm:[2,3,0,1] row_mask:0xf bank_mask:0xf
    v_max_f32 v6, v6, v55
    ds_write_b64 v52, v[54:55]
    v_add_u32 v52, 512, v52
    s_branch L_k_disp
L_k_m3:
    s_add_i32 s62, s62, 32
    s_xor_b32 s21, s18, 0x8400
    s_waitcnt vmcnt(6)
    buffer_load_dwordx4 v[108:111], v2, s[32:35], s21 offen offset:2048 nt
    v_mfma_f32_16x16x32_bf16 v[36:39], v[80:83], v[12:15], 0
    s_add_u32 s19, s19, 1
    s_bfe_u32 s18, s19, 0x20000
    s_lshl_b32 s18, s18, 16
    s_bfe_u32 s21, s19, 0x10002
    s_lshl_b32 s21, s21, 14
    s_or_b32 s18, s18, s21
    s_bfe_u32 s21, s19, 0x10003
    s_lshl_b32 s21, s21, 18
    s_or_b32 s18, s18, s21
    s_xor_b32 s18, s18, s56
    s_waitcnt vmcnt(6)
    buffer_load_dwordx4 v[80:83], v2, s[32:35], s18 offen offset:0 nt
    v_mfma_f32_16x16x32_bf16 v[40:43], v[84:87], v[12:15], 0
    s_xor_b32 s21, s18, 0x8000
    s_waitcnt vmcnt(6)
    buffer_load_dwordx4 v[84:87], v2, s[32:35], s21 offen offset:0 nt
    v_mfma_f32_16x16x32_bf16 v[44:47], v[88:91], v[12:15], 0
    s_xor_b32 s21, s18, 0x400
    s_waitcnt vmcnt(6)
    buffer_load_dwordx4 v[88:91], v2, s[32:35], s21 offen offset:0 nt
    v_mfma_f32_16x16x32_bf16 v[48:51], v[92:95], v[12:15], 0
    s_nop 7
    v_cndmask_b32 v8, v36, v41, s[24:25]
    v_cndmask_b32 v9, v40, v45, s[24:25]
    v_cndmask_b32 v10, v44, v49, s[24:25]
    v_cndmask_b32 v11, v48, v37, s[24:25]
    v_cndmask_b32 v8, v8, v46, s[26:27]
    v_cndmask_b32 v9, v9, v50, s[26:27]
    v_cndmask_b32 v10, v10, v38, s[26:27]
    v_cndmask_b32 v11, v11, v42, s[26:27]
    v_cndmask_b32 v10, v10, v43, s[28:29]
    v_cndmask_b32 v11, v11, v47, s[28:29]
    v_cndmask_b32 v8, v8, v51, s[28:29]
    v_cndmask_b32 v9, v9, v39, s[28:29]
    v_add_f32_dpp v10, v11, v10 quad_perm:[3,0,1,2] row_mask:0xf bank_mask:0xf
    s_nop 0
    v_add_f32_dpp v8, v9, v8 quad_perm:[3,0,1,2] row_mask:0xf bank_mask:0xf
    s_nop 1
    v_add_f32_dpp v54, v10, v8 quad_perm:[2,3,0,1] row_mask:0xf bank_mask:0xf
    v_max_f32 v6, v6, v54
    s_xor_b32 s21, s18, 0x8400
    s_waitcnt vmcnt(6)
    buffer_load_dwordx4 v[92:95], v2, s[32:35], s21 offen offset:0 nt
    v_mfma_f32_16x16x32_bf16 v[36:39], v[96:99], v[12:15], 0
    s_waitcnt vmcnt(6)
    buffer_load_dwordx4 v[96:99], v2, s[32:35], s18 offen offset:2048 nt
    v_mfma_f32_16x16x32_bf16 v[40:43], v[100:103], v[12:15], 0
    s_xor_b32 s21, s18, 0x8000
    s_waitcnt vmcnt(6)
    buffer_load_dwordx4 v[100:103], v2, s[32:35], s21 offen offset:2048 nt
    v_mfma_f32_16x16x32_bf16 v[44:47], v[104:107], v[12:15], 0
    s_xor_b32 s21, s18, 0x400
    s_waitcnt vmcnt(6)
    buffer_load_dwordx4 v[104:107], v2, s[32:35], s21 offen offset:2048 nt
    v_mfma_f32_16x16x32_bf16 v[48:51], v[108:111], v[12:15], 0
    s_nop 7
    v_cndmask_b32 v8, v36, v41, s[24:25]
    v_cndmask_b32 v9, v40, v45, s[24:25]
    v_cndmask_b32 v10, v44, v49, s[24:25]
    v_cndmask_b32 v11, v48, v37, s[24:25]
    v_cndmask_b32 v8, v8, v46, s[26:27]
    v_cndmask_b32 v9, v9, v50, s[26:27]
    v_cndmask_b32 v10, v10, v38, s[26:27]
    v_cndmask_b32 v11, v11, v42, s[26:27]
    v_cndmask_b32 v10, v10, v43, s[28:29]
    v_cndmask_b32 v11, v11, v47, s[28:29]
    v_cndmask_b32 v8, v8, v51, s[28:29]
    v_cndmask_b32 v9, v9, v39, s[28:29]
    v_add_f32_dpp v10, v11, v10 quad_perm:[3,0,1,2] row_mask:0xf bank_mask:0xf
    s_nop 0
    v_add_f32_dpp v8, v9, v8 quad_perm:[3,0,1,2] row_mask:0xf bank_mask:0xf
    s_nop 1
    v_add_f32_dpp v55, v10, v8 quad_perm:[2,3,0,1] row_mask:0xf bank_mask:0xf
    v_max_f32 v6, v6, v55
    ds_write_b64 v52, v[54:55]
    v_add_u32 v52, 512, v52
    s_branch L_k_disp
L_k_last:
    s_xor_b32 s21, s18, 0x8400
    s_waitcnt vmcnt(4)
    buffer_load_dwordx4 v[108:111], v2, s[32:35], s21 offen offset:2048 nt
    v_mfma_f32_16x16x32_bf16 v[36:39], v[80:83], v[12:15], 0
    s_mov_b32 s19, 0
    s_mov_b32 s18, s56
    s_waitcnt vmcnt(4)
    buffer_load_dwordx4 v[80:83], v3, s[36:39], s18 offen offset:0 nt
    v_mfma_f32_16x16x32_bf16 v[40:43], v[84:87], v[12:15], 0
    s_xor_b32 s21, s18, 0x8000
    s_waitcnt vmcnt(4)
    buffer_load_dwordx4 v[84:87], v3, s[36:39], s21 offen offset:0 nt
    v_mfma_f32_16x16x32_bf16 v[44:47], v[88:91], v[12:15], 0
    s_xor_b32 s21, s18, 0x400
    s_waitcnt vmcnt(4)
    buffer_load_dwordx4 v[88:91], v3, s[36:39], s21 offen offset:0 nt
    v_mfma_f32_16x16x32_bf16 v[48:51], v[92:95], v[12:15], 0
    s_nop 7
    v_cndmask_b32 v8, v36, v41, s[24:25]
    v_cndmask_b32 v9, v40, v45, s[24:25]
    v_cndmask_b32 v10, v44, v49, s[24:25]
    v_cndmask_b32 v11, v48, v37, s[24:25]
    v_cndmask_b32 v8, v8, v46, s[26:27]
    v_cndmask_b32 v9, v9, v50, s[26:27]
    v_cndmask_b32 v10, v10, v38, s[26:27]
    v_cndmask_b32 v11, v11, v42, s[26:27]
    v_cndmask_b32 v10, v10, v43, s[28:29]
    v_cndmask_b32 v11, v11, v47, s[28:29]
    v_cndmask_b32 v8, v8, v51, s[28:29]
    v_cndmask_b32 v9, v9, v39, s[28:29]
    v_add_f32_dpp v10, v11, v10 quad_perm:[3,0,1,2] row_mask:0xf bank_mask:0xf
    s_nop 0
    v_add_f32_dpp v8, v9, v8 quad_perm:[3,0,1,2] row_mask:0xf bank_mask:0xf
    s_nop 1
    v_add_f32_dpp v54, v10, v8 quad_perm:[2,3,0,1] row_mask:0xf bank_mask:0xf
    v_max_f32 v6, v6, v54
    s_xor_b32 s21, s18, 0x8400
    s_waitcnt vmcnt(4)
    buffer_load_dwordx4 v[92:95], v3, s[36:39], s21 offen offset:0 nt
    v_mfma_f32_16x16x32_bf16 v[36:39], v[96:99], v[12:15], 0
    s_waitcnt vmcnt(4)
    buffer_load_dwordx4 v[96:99], v3, s[36:39], s18 offen offset:2048 nt
    v_mfma_f32_16x16x32_bf16 v[40:43], v[100:103], v[12:15], 0
    s_xor_b32 s21, s18, 0x8000
    s_waitcnt vmcnt(4)
    buffer_load_dwordx4 v[100:103], v3, s[36:39], s21 offen offset:2048 nt
    v_mfma_f32_16x16x32_bf16 v[44:47], v[104:107], v[12:15], 0
    s_xor_b32 s21, s18, 0x400
    s_waitcnt vmcnt(4)
    buffer_load_dwordx4 v[104:107], v3, s[36:39], s21 offen offset:2048 nt
    v_mfma_f32_16x16x32_bf16 v[48:51], v[108:111], v[12:15], 0
    s_nop 7
    v_cndmask_b32 v8, v36, v41, s[24:25]
    v_cndmask_b32 v9, v40, v45, s[24:25]
    v_cndmask_b32 v10, v44, v49, s[24:25]
    v_cndmask_b32 v11, v48, v37, s[24:25]
    v_cndmask_b32 v8, v8, v46, s[26:27]
    v_cndmask_b32 v9, v9, v50, s[26:27]
    v_cndmask_b32 v10, v10, v38, s[26:27]
    v_cndmask_b32 v11, v11, v42, s[26:27]
    v_cndmask_b32 v10, v10, v43, s[28:29]
    v_cndmask_b32 v11, v11, v47, s[28:29]
    v_cndmask_b32 v8, v8, v51, s[28:29]
    v_cndmask_b32 v9, v9, v39, s[28:29]
    v_add_f32_dpp v10, v11, v10 quad_perm:[3,0,1,2] row_mask:0xf bank_mask:0xf
    s_nop 0
    v_add_f32_dpp v8, v9, v8 quad_perm:[3,0,1,2] row_mask:0xf bank_mask:0xf
    s_nop 1
    v_add_f32_dpp v55, v10, v8 quad_perm:[2,3,0,1] row_mask:0xf bank_mask:0xf
    v_max_f32 v6, v6, v55
    ds_write_b64 v52, v[54:55]
    v_add_u32 v52, 512, v52
    buffer_load_dwordx4 v[16:19], v2, s[44:47], 0 offen
    v_and_b32 v8, 0xf0, v3
    buffer_load_dwordx4 v[20:23], v8, s[48:51], 0 offen
    v_subrev_u32 v52, 8192, v52
    ds_read_b64 v[54:55], v52
    v_max_f32_dpp v6, v6, v6 quad_perm:[1,0,3,2] row_mask:0xf bank_mask:0xf
    s_nop 1
    v_max_f32_dpp v6, v6, v6 quad_perm:[2,3,0,1] row_mask:0xf bank_mask:0xf
    s_nop 0
    v_mov_b32 v8, v6
    s_nop 1
    v_permlane16_swap_b32 v8, v6
    s_nop 1
    v_max_f32 v6, v6, v8
    s_nop 0
    v_mov_b32 v8, v6
    s_nop 1
    v_permlane32_swap_b32 v8, v6
    s_nop 1
    v_max_f32 v6, v6, v8
    v_mul_f32 v6, s22, v6
    s_waitcnt lgkmcnt(0)
    v_fma_f32 v54, v54, s22, -v6
    v_fma_f32 v55, v55, s22, -v6
    v_exp_f32 v54, v54
    v_exp_f32 v55, v55
    s_nop 0
    v_add_f32 v7, v7, v54
    v_add_f32 v7, v7, v55
    v_cvt_pk_bf16_f32 v56, v54, v54
    v_cvt_pk_bf16_f32 v57, v55, v55
    v_add_u32 v52, 512, v52
    ds_read_b64 v[54:55], v52
    v_and_b32_dpp v24, v56, v4 quad_perm:[0,0,0,0] row_mask:0xf bank_mask:0xf
    v_and_b32_dpp v25, v56, v5 quad_perm:[0,0,0,0] row_mask:0xf bank_mask:0xf
    s_xor_b32 s21, s18, 0x8400
    s_waitcnt vmcnt(6)
    buffer_load_dwordx4 v[108:111], v3, s[36:39], s21 offen offset:2048 nt
    v_mfma_f32_16x16x16_bf16 v[28:31], v[24:25], v[80:81], v[28:31]
    v_mfma_f32_16x16x16_bf16 v[32:35], v[24:25], v[82:83], v[32:35]
    v_and_b32_dpp v26, v56, v4 quad_perm:[1,1,1,1] row_mask:0xf bank_mask:0xf
    v_and_b32_dpp v27, v56, v5 quad_perm:[1,1,1,1] row_mask:0xf bank_mask:0xf
    s_add_u32 s19, s19, 1
    s_bfe_u32 s18, s19, 0x20000
    s_lshl_b32 s18, s18, 16
    s_bfe_u32 s21, s19, 0x10002
    s_lshl_b32 s21, s21, 14
    s_or_b32 s18, s18, s21
    s_bfe_u32 s21, s19, 0x10003
    s_lshl_b32 s21, s21, 18
    s_or_b32 s18, s18, s21
    s_xor_b32 s18, s18, s56
    s_waitcnt vmcnt(6)
    buffer_load_dwordx4 v[80:83], v3, s[36:39], s18 offen offset:0 nt
    v_mfma_f32_16x16x16_bf16 v[28:31], v[26:27], v[84:85], v[28:31]
    v_mfma_f32_16x16x16_bf16 v[32:35], v[26:27], v[86:87], v[32:35]
    v_and_b32_dpp v24, v56, v4 quad_perm:[2,2,2,2] row_mask:0xf bank_mask:0xf
    v_and_b32_dpp v25, v56, v5 quad_perm:[2,2,2,2] row_mask:0xf bank_mask:0xf
    s_xor_b32 s21, s18, 0x8000
    s_waitcnt vmcnt(6)
    buffer_load_dwordx4 v[84:87], v3, s[36:39], s21 offen offset:0 nt
    v_mfma_f32_16x16x16_bf16 v[28:31], v[24:25], v[88:89], v[28:31]
    v_mfma_f32_16x16x16_bf16 v[32:35], v[24:25], v[90:91], v[32:35]
    v_and_b32_dpp v26, v56, v4 quad_perm:[3,3,3,3] row_mask:0xf bank_mask:0xf
    v_and_b32_dpp v27, v56, v5 quad_perm:[3,3,3,3] row_mask:0xf bank_mask:0xf
    s_xor_b32 s21, s18, 0x400
    s_waitcnt vmcnt(6)
    buffer_load_dwordx4 v[88:91], v3, s[36:39], s21 offen offset:0 nt
    v_mfma_f32_16x16x16_bf16 v[28:31], v[26:27], v[92:93], v[28:31]
    v_mfma_f32_16x16x16_bf16 v[32:35], v[26:27], v[94:95], v[32:35]
    v_and_b32_dpp v24, v57, v4 quad_perm:[0,0,0,0] row_mask:0xf bank_mask:0xf
    v_and_b32_dpp v25, v57, v5 quad_perm:[0,0,0,0] row_mask:0xf bank_mask:0xf
    s_xor_b32 s21, s18, 0x8400
    s_waitcnt vmcnt(6)
    buffer_load_dwordx4 v[92:95], v3, s[36:39], s21 offen offset:0 nt
    v_mfma_f32_16x16x16_bf16 v[28:31], v[24:25], v[96:97], v[28:31]
    v_mfma_f32_16x16x16_bf16 v[32:35], v[24:25], v[98:99], v[32:35]
    v_and_b32_dpp v26, v57, v4 quad_perm:[1,1,1,1] row_mask:0xf bank_mask:0xf
    v_and_b32_dpp v27, v57, v5 quad_perm:[1,1,1,1] row_mask:0xf bank_mask:0xf
    s_waitcnt vmcnt(4)
    buffer_load_dwordx4 v[96:99], v3, s[36:39], s18 offen offset:2048 nt
    v_mfma_f32_16x16x16_bf16 v[28:31], v[26:27], v[100:101], v[28:31]
    v_mfma_f32_16x16x16_bf16 v[32:35], v[26:27], v[102:103], v[32:35]
    s_waitcnt lgkmcnt(0)
    v_fma_f32 v54, v54, s22, -v6
    v_fma_f32 v55, v55, s22, -v6
    v_exp_f32 v54, v54
    v_exp_f32 v55, v55
    s_nop 0
    v_add_f32 v7, v7, v54
    v_add_f32 v7, v7, v55
    v_cvt_pk_bf16_f32 v56, v54, v54
    v_and_b32_dpp v24, v57, v4 quad_perm:[2,2,2,2] row_mask:0xf bank_mask:0xf
    v_and_b32_dpp v25, v57, v5 quad_perm:[2,2,2,2] row_mask:0xf bank_mask:0xf
    s_xor_b32 s21, s18, 0x8000
    s_waitcnt vmcnt(4)
    buffer_load_dwordx4 v[100:103], v3, s[36:39], s21 offen offset:2048 nt
    v_mfma_f32_16x16x16_bf16 v[28:31], v[24:25], v[104:105], v[28:31]
    v_mfma_f32_16x16x16_bf16 v[32:35], v[24:25], v[106:107], v[32:35]
    v_and_b32_dpp v26, v57, v4 quad_perm:[3,3,3,3] row_mask:0xf bank_mask:0xf
    v_and_b32_dpp v27, v57, v5 quad_perm:[3,3,3,3] row_mask:0xf bank_mask:0xf
    s_xor_b32 s21, s18, 0x400
    s_waitcnt vmcnt(4)
    buffer_load_dwordx4 v[104:107], v3, s[36:39], s21 offen offset:2048 nt
    v_mfma_f32_16x16x16_bf16 v[28:31], v[26:27], v[108:109], v[28:31]
    v_mfma_f32_16x16x16_bf16 v[32:35], v[26:27], v[110:111], v[32:35]
    v_cvt_pk_bf16_f32 v57, v55, v55
    v_mfma_f32_16x16x32_bf16 v[36:39], v[16:19], v[12:15], 0
    s_bitcmp1_b32 s2, 3
    s_cselect_b32 s57, 0, 16
    s_lshl_b32 s23, s23, s57
    s_and_b32 s23, s23, 0xffff0000
    s_mov_b32 s30, 14
    s_nop 4
    v_cndmask_b32 v8, v36, v37, s[24:25]
    v_cndmask_b32 v8, v8, v38, s[26:27]
    v_cndmask_b32 v8, v8, v39, s[28:29]
    v_mov_b32 v9, s23
    v_sub_f32 v9, 1.0, v9
    v_add_f32_dpp v8, v8, v8 quad_perm:[1,0,3,2] row_mask:0xf bank_mask:0xf
    v_mul_f32 v9, 0xceabfb8f, v9
    s_nop 0
    v_add_f32_dpp v8, v8, v8 quad_perm:[2,3,0,1] row_mask:0xf bank_mask:0xf
    s_nop 0
    v_fma_f32 v16, v8, s22, v9
    v_mov_b32 v17, 1.0
L_v_disp:
    s_sub_u32 s30, s30, 1
    s_cbranch_scc1 L_v_last
    s_waitcnt lgkmcnt(0)
    v_readfirstlane_b32 s58, v58
    v_readfirstlane_b32 s59, v59
    s_add_u32 s57, s60, s64
    v_writelane_b32 v53, s57, m0
    s_sub_i32 s62, s62, s65
    s_cmp_lg_u32 s20, s31
    s_cbranch_scc1 L_v_nopub
    s_or_b32 s57, s60, 1
    v_mov_b32 v8, s57
    s_lshl_b32 s57, m0, 2
    v_mov_b32 v9, s57
    ds_write_b32 v9, v8 offset:41216
L_v_nopub:
    ds_read_b64 v[58:59], v0 offset:41472
    s_memrealtime s[60:61]
    s_mov_b32 s64, s62
    s_add_u32 m0, m0, 1
    s_cmp_lt_i32 s58, 0
    s_cbranch_scc1 L_v_pick
    v_readlane_b32 s57, v53, s58
    s_add_i32 s63, s62, 200
    s_sub_i32 s57, s57, s59
    s_cmp_ge_u32 s58, m0
    s_cselect_b32 s63, s63, s57
L_v_pick:
    s_sub_i32 s57, s63, s62
    s_cmp_lt_u32 s30, 2
    s_cselect_b32 s58, 15, 0
    s_add_i32 s57, s57, s58
    s_cmp_gt_i32 s57, 40
    s_cbranch_scc1 L_v_m3
    s_cmp_gt_i32 s57, 10
    s_cbranch_scc1 L_v_m2
    s_cmp_lt_i32 s57, -35
    s_cbranch_scc1 L_v_m0
L_v_m1:
    v_add_u32 v52, 512, v52
    ds_read_b64 v[54:55], v52
    v_and_b32_dpp v24, v56, v4 quad_perm:[0,0,0,0] row_mask:0xf bank_mask:0xf
    v_and_b32_dpp v25, v56, v5 quad_perm:[0,0,0,0] row_mask:0xf bank_mask:0xf
    s_xor_b32 s21, s18, 0x8400
    s_waitcnt vmcnt(4)
    buffer_load_dwordx4 v[108:111], v3, s[36:39], s21 offen offset:2048 nt
    v_mfma_f32_16x16x16_bf16 v[28:31], v[24:25], v[80:81], v[28:31]
    v_mfma_f32_16x16x16_bf16 v[32:35], v[24:25], v[82:83], v[32:35]
    v_and_b32_dpp v26, v56, v4 quad_perm:[1,1,1,1] row_mask:0xf bank_mask:0xf
    v_and_b32_dpp v27, v56, v5 quad_perm:[1,1,1,1] row_mask:0xf bank_mask:0xf
    s_add_u32 s19, s19, 1
    s_bfe_u32 s18, s19, 0x20000
    s_lshl_b32 s18, s18, 16
    s_bfe_u32 s21, s19, 0x10002
    s_lshl_b32 s21, s21, 14
    s_or_b32 s18, s18, s21
    s_bfe_u32 s21, s19, 0x10003
    s_lshl_b32 s21, s21, 18
    s_or_b32 s18, s18, s21
    s_xor_b32 s18, s18, s56
    s_waitcnt vmcnt(4)
    buffer_load_dwordx4 v[80:83], v3, s[36:39], s18 offen offset:0 nt
    v_mfma_f32_16x16x16_bf16 v[28:31], v[26:27], v[84:85], v[28:31]
    v_mfma_f32_16x16x16_bf16 v[32:35], v[26:27], v[86:87], v[32:35]
    v_and_b32_dpp v24, v56, v4 quad_perm:[2,2,2,2] row_mask:0xf bank_mask:0xf
    v_and_b32_dpp v25, v56, v5 quad_perm:[2,2,2,2] row_mask:0xf bank_mask:0xf
    s_xor_b32 s21, s18, 0x8000
    s_waitcnt vmcnt(4)
    buffer_load_dwordx4 v[84:87], v3, s[36:39], s21 offen offset:0 nt
    v_mfma_f32_16x16x16_bf16 v[28:31], v[24:25], v[88:89], v[28:31]
    v_mfma_f32_16x16x16_bf16 v[32:35], v[24:25], v[90:91], v[32:35]
    v_and_b32_dpp v26, v56, v4 quad_perm:[3,3,3,3] row_mask:0xf bank_mask:0xf
    v_and_b32_dpp v27, v56, v5 quad_perm:[3,3,3,3] row_mask:0xf bank_mask:0xf
    s_xor_b32 s21, s18, 0x400
    s_waitcnt vmcnt(4)
    buffer_load_dwordx4 v[88:91], v3, s[36:39], s21 offen offset:0 nt
    v_mfma_f32_16x16x16_bf16 v[28:31], v[26:27], v[92:93], v[28:31]
    v_mfma_f32_16x16x16_bf16 v[32:35], v[26:27], v[94:95], v[32:35]
    v_and_b32_dpp v24, v57, v4 quad_perm:[0,0,0,0] row_mask:0xf bank_mask:0xf
    v_and_b32_dpp v25, v57, v5 quad_perm:[0,0,0,0] row_mask:0xf bank_mask:0xf
    s_xor_b32 s21, s18, 0x8400
    s_waitcnt vmcnt(4)
    buffer_load_dwordx4 v[92:95], v3, s[36:39], s21 offen offset:0 nt
    v_mfma_f32_16x16x16_bf16 v[28:31], v[24:25], v[96:97], v[28:31]
    v_mfma_f32_16x16x16_bf16 v[32:35], v[24:25], v[98:99], v[32:35]
    v_and_b32_dpp v26, v57, v4 quad_perm:[1,1,1,1] row_mask:0xf bank_mask:0xf
    v_and_b32_dpp v27, v57, v5 quad_perm:[1,1,1,1] row_mask:0xf bank_mask:0xf
    s_waitcnt vmcnt(4)
    buffer_load_dwordx4 v[96:99], v3, s[36:39], s18 offen offset:2048 nt
    v_mfma_f32_16x16x16_bf16 v[28:31], v[26:27], v[100:101], v[28:31]
    v_mfma_f32_16x16x16_bf16 v[32:35], v[26:27], v[102:103], v[32:35]
    s_waitcnt lgkmcnt(0)
    v_fma_f32 v54, v54, s22, -v6
    v_fma_f32 v55, v55, s22, -v6
    v_exp_f32 v54, v54
    v_exp_f32 v55, v55
    s_nop 0
    v_add_f32 v7, v7, v54
    v_add_f32 v7, v7, v55
    v_cvt_pk_bf16_f32 v56, v54, v54
    v_and_b32_dpp v24, v57, v4 quad_perm:[2,2,2,2] row_mask:0xf bank_mask:0xf
    v_and_b32_dpp v25, v57, v5 quad_perm:[2,2,2,2] row_mask:0xf bank_mask:0xf
    s_xor_b32 s21, s18, 0x8000
    s_waitcnt vmcnt(4)
    buffer_load_dwordx4 v[100:103], v3, s[36:39], s21 offen offset:2048 nt
    v_mfma_f32_16x16x16_bf16 v[28:31], v[24:25], v[104:105], v[28:31]
    v_mfma_f32_16x16x16_bf16 v[32:35], v[24:25], v[106:107], v[32:35]
    v_and_b32_dpp v26, v57, v4 quad_perm:[3,3,3,3] row_mask:0xf bank_mask:0xf
    v_and_b32_dpp v27, v57, v5 quad_perm:[3,3,3,3] row_mask:0xf bank_mask:0xf
    s_xor_b32 s21, s18, 0x400
    s_waitcnt vmcnt(4)
    buffer_load_dwordx4 v[104:107], v3, s[36:39], s21 offen offset:2048 nt
    v_mfma_f32_16x16x16_bf16 v[28:31], v[26:27], v[108:109], v[28:31]
    v_mfma_f32_16x16x16_bf16 v[32:35], v[26:27], v[110:111], v[32:35]
    v_cvt_pk_bf16_f32 v57, v55, v55
    s_branch L_v_disp
L_v_m0:
    s_add_i32 s62, s62, -28
    v_add_u32 v52, 512, v52
    ds_read_b64 v[54:55], v52
    v_and_b32_dpp v24, v56, v4 quad_perm:[0,0,0,0] row_mask:0xf bank_mask:0xf
    v_and_b32_dpp v25, v56, v5 quad_perm:[0,0,0,0] row_mask:0xf bank_mask:0xf
    s_xor_b32 s21, s18, 0x8400
    s_waitcnt vmcnt(3)
    buffer_load_dwordx4 v[108:111], v3, s[36:39], s21 offen offset:2048 nt
    v_mfma_f32_16x16x16_bf16 v[28:31], v[24:25], v[80:81], v[28:31]
    v_mfma_f32_16x16x16_bf16 v[32:35], v[24:25], v[82:83], v[32:35]
    v_and_b32_dpp v26, v56, v4 quad_perm:[1,1,1,1] row_mask:0xf bank_mask:0xf
    v_and_b32_dpp v27, v56, v5 quad_perm:[1,1,1,1] row_mask:0xf bank_mask:0xf
    s_add_u32 s19, s19, 1
    s_bfe_u32 s18, s19, 0x20000
    s_lshl_b32 s18, s18, 16
    s_bfe_u32 s21, s19, 0x10002
    s_lshl_b32 s21, s21, 14
    s_or_b32 s18, s18, s21
    s_bfe_u32 s21, s19, 0x10003
    s_lshl_b32 s21, s21, 18
    s_or_b32 s18, s18, s21
    s_xor_b32 s18, s18, s56
    s_waitcnt vmcnt(3)
    buffer_load_dwordx4 v[80:83], v3, s[36:39], s18 offen offset:0 nt
    v_mfma_f32_16x16x16_bf16 v[28:31], v[26:27], v[84:85], v[28:31]
    v_mfma_f32_16x16x16_bf16 v[32:35], v[26:27], v[86:87], v[32:35]
    v_and_b32_dpp v24, v56, v4 quad_perm:[2,2,2,2] row_mask:0xf bank_mask:0xf
    v_and_b32_dpp v25, v56, v5 quad_perm:[2,2,2,2] row_mask:0xf bank_mask:0xf
    s_xor_b32 s21, s18, 0x8000
    s_waitcnt vmcnt(3)
    buffer_load_dwordx4 v[84:87], v3, s[36:39], s21 offen offset:0 nt
    v_mfma_f32_16x16x16_bf16 v[28:31], v[24:25], v[88:89], v[28:31]
    v_mfma_f32_16x16x16_bf16 v[32:35], v[24:25], v[90:91], v[32:35]
    v_and_b32_dpp v26, v56, v4 quad_perm:[3,3,3,3] row_mask:0xf bank_mask:0xf
    v_and_b32_dpp v27, v56, v5 quad_perm:[3,3,3,3] row_mask:0xf bank_mask:0xf
    s_xor_b32 s21, s18, 0x400
    s_waitcnt vmcnt(3)
    buffer_load_dwordx4 v[88:91], v3, s[36:39], s21 offen offset:0 nt
    v_mfma_f32_16x16x16_bf16 v[28:31], v[26:27], v[92:93], v[28:31]
    v_mfma_f32_16x16x16_bf16 v[32:35], v[26:27], v[94:95], v[32:35]
    v_and_b32_dpp v24, v57, v4 quad_perm:[0,0,0,0] row_mask:0xf bank_mask:0xf
    v_and_b32_dpp v25, v57, v5 quad_perm:[0,0,0,0] row_mask:0xf bank_mask:0xf
    s_xor_b32 s21, s18, 0x8400
    s_waitcnt vmcnt(3)
    buffer_load_dwordx4 v[92:95], v3, s[36:39], s21 offen offset:0 nt
    v_mfma_f32_16x16x16_bf16 v[28:31], v[24:25], v[96:97], v[28:31]
    v_mfma_f32_16x16x16_bf16 v[32:35], v[24:25], v[98:99], v[32:35]
    v_and_b32_dpp v26, v57, v4 quad_perm:[1,1,1,1] row_mask:0xf bank_mask:0xf
    v_and_b32_dpp v27, v57, v5 quad_perm:[1,1,1,1] row_mask:0xf bank_mask:0xf
    s_waitcnt vmcnt(3)
    buffer_load_dwordx4 v[96:99], v3, s[36:39], s18 offen offset:2048 nt
    v_mfma_f32_16x16x16_bf16 v[28:31], v[26:27], v[100:101], v[28:31]
    v_mfma_f32_16x16x16_bf16 v[32:35], v[26:27], v[102:103], v[32:35]
    s_waitcnt lgkmcnt(0)
    v_fma_f32 v54, v54, s22, -v6
    v_fma_f32 v55, v55, s22, -v6
    v_exp_f32 v54, v54
    v_exp_f32 v55, v55
    s_nop 0
    v_add_f32 v7, v7, v54
    v_add_f32 v7, v7, v55
    v_cvt_pk_bf16_f32 v56, v54, v54
    v_and_b32_dpp v24, v57, v4 quad_perm:[2,2,2,2] row_mask:0xf bank_mask:0xf
    v_and_b32_dpp v25, v57, v5 quad_perm:[2,2,2,2] row_mask:0xf bank_mask:0xf
    s_xor_b32 s21, s18, 0x8000
    s_waitcnt vmcnt(3)
    buffer_load_dwordx4 v[100:103], v3, s[36:39], s21 offen offset:2048 nt
    v_mfma_f32_16x16x16_bf16 v[28:31], v[24:25], v[104:105], v[28:31]
    v_mfma_f32_16x16x16_bf16 v[32:35], v[24:25], v[106:107], v[32:35]
    v_and_b32_dpp v26, v57, v4 quad_perm:[3,3,3,3] row_mask:0xf bank_mask:0xf
    v_and_b32_dpp v27, v57, v5 quad_perm:[3,3,3,3] row_mask:0xf bank_mask:0xf
    s_xor_b32 s21, s18, 0x400
    s_waitcnt vmcnt(3)
    buffer_load_dwordx4 v[104:107], v3, s[36:39], s21 offen offset:2048 nt
    v_mfma_f32_16x16x16_bf16 v[28:31], v[26:27], v[108:109], v[28:31]
    v_mfma_f32_16x16x16_bf16 v[32:35], v[26:27], v[110:111], v[32:35]
    v_cvt_pk_bf16_f32 v57, v55, v55
    s_branch L_v_disp
L_v_m2:
    s_add_i32 s62, s62, 19
    v_add_u32 v52, 512, v52
    ds_read_b64 v[54:55], v52
    v_and_b32_dpp v24, v56, v4 quad_perm:[0,0,0,0] row_mask:0xf bank_mask:0xf
    v_and_b32_dpp v25, v56, v5 quad_perm:[0,0,0,0] row_mask:0xf bank_mask:0xf
    s_xor_b32 s21, s18, 0x8400
    s_waitcnt vmcnt(5)
    buffer_load_dwordx4 v[108:111], v3, s[36:39], s21 offen offset:2048 nt
    v_mfma_f32_16x16x16_bf16 v[28:31], v[24:25], v[80:81], v[28:31]
    v_mfma_f32_16x16x16_bf16 v[32:35], v[24:25], v[82:83], v[32:35]
    v_and_b32_dpp v26, v56, v4 quad_perm:[1,1,1,1] row_mask:0xf bank_mask:0xf
    v_and_b32_dpp v27, v56, v5 quad_perm:[1,1,1,1] row_mask:0xf bank_mask:0xf
    s_add_u32 s19, s19, 1
    s_bfe_u32 s18, s19, 0x20000
    s_lshl_b32 s18, s18, 16
    s_bfe_u32 s21, s19, 0x10002
    s_lshl_b32 s21, s21, 14
    s_or_b32 s18, s18, s21
    s_bfe_u32 s21, s19, 0x10003
    s_lshl_b32 s21, s21, 18
    s_or_b32 s18, s18, s21
    s_xor_b32 s18, s18, s56
    s_waitcnt vmcnt(5)
    buffer_load_dwordx4 v[80:83], v3, s[36:39], s18 offen offset:0 nt
    v_mfma_f32_16x16x16_bf16 v[28:31], v[26:27], v[84:85], v[28:31]
    v_mfma_f32_16x16x16_bf16 v[32:35], v[26:27], v[86:87], v[32:35]
    v_and_b32_dpp v24, v56, v4 quad_perm:[2,2,2,2] row_mask:0xf bank_mask:0xf
    v_and_b32_dpp v25, v56, v5 quad_perm:[2,2,2,2] row_mask:0xf bank_mask:0xf
    s_xor_b32 s21, s18, 0x8000
    s_waitcnt vmcnt(5)
    buffer_load_dwordx4 v[84:87], v3, s[36:39], s21 offen offset:0 nt
    v_mfma_f32_16x16x16_bf16 v[28:31], v[24:25], v[88:89], v[28:31]
    v_mfma_f32_16x16x16_bf16 v[32:35], v[24:25], v[90:91], v[32:35]
    v_and_b32_dpp v26, v56, v4 quad_perm:[3,3,3,3] row_mask:0xf bank_mask:0xf
    v_and_b32_dpp v27, v56, v5 quad_perm:[3,3,3,3] row_mask:0xf bank_mask:0xf
    s_xor_b32 s21, s18, 0x400
    s_waitcnt vmcnt(5)
    buffer_load_dwordx4 v[88:91], v3, s[36:39], s21 offen offset:0 nt
    v_mfma_f32_16x16x16_bf16 v[28:31], v[26:27], v[92:93], v[28:31]
    v_mfma_f32_16x16x16_bf16 v[32:35], v[26:27], v[94:95], v[32:35]
    v_and_b32_dpp v24, v57, v4 quad_perm:[0,0,0,0] row_mask:0xf bank_mask:0xf
    v_and_b32_dpp v25, v57, v5 quad_perm:[0,0,0,0] row_mask:0xf bank_mask:0xf
    s_xor_b32 s21, s18, 0x8400
    s_waitcnt vmcnt(5)
    buffer_load_dwordx4 v[92:95], v3, s[36:39], s21 offen offset:0 nt
    v_mfma_f32_16x16x16_bf16 v[28:31], v[24:25], v[96:97], v[28:31]
    v_mfma_f32_16x16x16_bf16 v[32:35], v[24:25], v[98:99], v[32:35]
    v_and_b32_dpp v26, v57, v4 quad_perm:[1,1,1,1] row_mask:0xf bank_mask:0xf
    v_and_b32_dpp v27, v57, v5 quad_perm:[1,1,1,1] row_mask:0xf bank_mask:0xf
    s_waitcnt vmcnt(5)
    buffer_load_dwordx4 v[96:99], v3, s[36:39], s18 offen offset:2048 nt
    v_mfma_f32_16x16x16_bf16 v[28:31], v[26:27], v[100:101], v[28:31]
    v_mfma_f32_16x16x16_bf16 v[32:35], v[26:27], v[102:103], v[32:35]
    s_waitcnt lgkmcnt(0)
    v_fma_f32 v54, v54, s22, -v6
    v_fma_f32 v55, v55, s22, -v6
    v_exp_f32 v54, v54
    v_exp_f32 v55, v55
    s_nop 0
    v_add_f32 v7, v7, v54
    v_add_f32 v7, v7, v55
    v_cvt_pk_bf16_f32 v56, v54, v54
    v_and_b32_dpp v24, v57, v4 quad_perm:[2,2,2,2] row_mask:0xf bank_mask:0xf
    v_and_b32_dpp v25, v57, v5 quad_perm:[2,2,2,2] row_mask:0xf bank_mask:0xf
    s_xor_b32 s21, s18, 0x8000
    s_waitcnt vmcnt(5)
    buffer_load_dwordx4 v[100:103], v3, s[36:39], s21 offen offset:2048 nt
    v_mfma_f32_16x16x16_bf16 v[28:31], v[24:25], v[104:105], v[28:31]
    v_mfma_f32_16x16x16_bf16 v[32:35], v[24:25], v[106:107], v[32:35]
    v_and_b32_dpp v26, v57, v4 quad_perm:[3,3,3,3] row_mask:0xf bank_mask:0xf
    v_and_b32_dpp v27, v57, v5 quad_perm:[3,3,3,3] row_mask:0xf bank_mask:0xf
    s_xor_b32 s21, s18, 0x400
    s_waitcnt vmcnt(5)
    buffer_load_dwordx4 v[104:107], v3, s[36:39], s21 offen offset:2048 nt
    v_mfma_f32_16x16x16_bf16 v[28:31], v[26:27], v[108:109], v[28:31]
    v_mfma_f32_16x16x16_bf16 v[32:35], v[26:27], v[110:111], v[32:35]
    v_cvt_pk_bf16_f32 v57, v55, v55
    s_branch L_v_disp
L_v_m3:
    s_add_i32 s62, s62, 32
    v_add_u32 v52, 512, v52
    ds_read_b64 v[54:55], v52
    v_and_b32_dpp v24, v56, v4 quad_perm:[0,0,0,0] row_mask:0xf bank_mask:0xf
    v_and_b32_dpp v25, v56, v5 quad_perm:[0,0,0,0] row_mask:0xf bank_mask:0xf
    s_xor_b32 s21, s18, 0x8400
    s_waitcnt vmcnt(6)
    buffer_load_dwordx4 v[108:111], v3, s[36:39], s21 offen offset:2048 nt
    v_mfma_f32_16x16x16_bf16 v[28:31], v[24:25], v[80:81], v[28:31]
    v_mfma_f32_16x16x16_bf16 v[32:35], v[24:25], v[82:83], v[32:35]
    v_and_b32_dpp v26, v56, v4 quad_perm:[1,1,1,1] row_mask:0xf bank_mask:0xf
    v_and_b32_dpp v27, v56, v5 quad_perm:[1,1,1,1] row_mask:0xf bank_mask:0xf
    s_add_u32 s19, s19, 1
    s_bfe_u32 s18, s19, 0x20000
    s_lshl_b32 s18, s18, 16
    s_bfe_u32 s21, s19, 0x10002
    s_lshl_b32 s21, s21, 14
    s_or_b32 s18, s18, s21
    s_bfe_u32 s21, s19, 0x10003
    s_lshl_b32 s21, s21, 18
    s_or_b32 s18, s18, s21
    s_xor_b32 s18, s18, s56
    s_waitcnt vmcnt(6)
    buffer_load_dwordx4 v[80:83], v3, s[36:39], s18 offen offset:0 nt
    v_mfma_f32_16x16x16_bf16 v[28:31], v[26:27], v[84:85], v[28:31]
    v_mfma_f32_16x16x16_bf16 v[32:35], v[26:27], v[86:87], v[32:35]
    v_and_b32_dpp v24, v56, v4 quad_perm:[2,2,2,2] row_mask:0xf bank_mask:0xf
    v_and_b32_dpp v25, v56, v5 quad_perm:[2,2,2,2] row_mask:0xf bank_mask:0xf
    s_xor_b32 s21, s18, 0x8000
    s_waitcnt vmcnt(6)
    buffer_load_dwordx4 v[84:87], v3, s[36:39], s21 offen offset:0 nt
    v_mfma_f32_16x16x16_bf16 v[28:31], v[24:25], v[88:89], v[28:31]
    v_mfma_f32_16x16x16_bf16 v[32:35], v[24:25], v[90:91], v[32:35]
    v_and_b32_dpp v26, v56, v4 quad_perm:[3,3,3,3] row_mask:0xf bank_mask:0xf
    v_and_b32_dpp v27, v56, v5 quad_perm:[3,3,3,3] row_mask:0xf bank_mask:0xf
    s_xor_b32 s21, s18, 0x400
    s_waitcnt vmcnt(6)
    buffer_load_dwordx4 v[88:91], v3, s[36:39], s21 offen offset:0 nt
    v_mfma_f32_16x16x16_bf16 v[28:31], v[26:27], v[92:93], v[28:31]
    v_mfma_f32_16x16x16_bf16 v[32:35], v[26:27], v[94:95], v[32:35]
    v_and_b32_dpp v24, v57, v4 quad_perm:[0,0,0,0] row_mask:0xf bank_mask:0xf
    v_and_b32_dpp v25, v57, v5 quad_perm:[0,0,0,0] row_mask:0xf bank_mask:0xf
    s_xor_b32 s21, s18, 0x8400
    s_waitcnt vmcnt(6)
    buffer_load_dwordx4 v[92:95], v3, s[36:39], s21 offen offset:0 nt
    v_mfma_f32_16x16x16_bf16 v[28:31], v[24:25], v[96:97], v[28:31]
    v_mfma_f32_16x16x16_bf16 v[32:35], v[24:25], v[98:99], v[32:35]
    v_and_b32_dpp v26, v57, v4 quad_perm:[1,1,1,1] row_mask:0xf bank_mask:0xf
    v_and_b32_dpp v27, v57, v5 quad_perm:[1,1,1,1] row_mask:0xf bank_mask:0xf
    s_waitcnt vmcnt(6)
    buffer_load_dwordx4 v[96:99], v3, s[36:39], s18 offen offset:2048 nt
    v_mfma_f32_16x16x16_bf16 v[28:31], v[26:27], v[100:101], v[28:31]
    v_mfma_f32_16x16x16_bf16 v[32:35], v[26:27], v[102:103], v[32:35]
    s_waitcnt lgkmcnt(0)
    v_fma_f32 v54, v54, s22, -v6
    v_fma_f32 v55, v55, s22, -v6
    v_exp_f32 v54, v54
    v_exp_f32 v55, v55
    s_nop 0
    v_add_f32 v7, v7, v54
    v_add_f32 v7, v7, v55
    v_cvt_pk_bf16_f32 v56, v54, v54
    v_and_b32_dpp v24, v57, v4 quad_perm:[2,2,2,2] row_mask:0xf bank_mask:0xf
    v_and_b32_dpp v25, v57, v5 quad_perm:[2,2,2,2] row_mask:0xf bank_mask:0xf
    s_xor_b32 s21, s18, 0x8000
    s_waitcnt vmcnt(6)
    buffer_load_dwordx4 v[100:103], v3, s[36:39], s21 offen offset:2048 nt
    v_mfma_f32_16x16x16_bf16 v[28:31], v[24:25], v[104:105], v[28:31]
    v_mfma_f32_16x16x16_bf16 v[32:35], v[24:25], v[106:107], v[32:35]
    v_and_b32_dpp v26, v57, v4 quad_perm:[3,3,3,3] row_mask:0xf bank_mask:0xf
    v_and_b32_dpp v27, v57, v5 quad_perm:[3,3,3,3] row_mask:0xf bank_mask:0xf
    s_xor_b32 s21, s18, 0x400
    s_waitcnt vmcnt(6)
    buffer_load_dwordx4 v[104:107], v3, s[36:39], s21 offen offset:2048 nt
    v_mfma_f32_16x16x16_bf16 v[28:31], v[26:27], v[108:109], v[28:31]
    v_mfma_f32_16x16x16_bf16 v[32:35], v[26:27], v[110:111], v[32:35]
    v_cvt_pk_bf16_f32 v57, v55, v55
    s_branch L_v_disp
L_v_last:
    s_xor_b32 s21, s18, 0x8400
    buffer_load_dwordx4 v[108:111], v3, s[36:39], s21 offen offset:2048 nt
    s_nop 1
    v_add_f32_dpp v7, v7, v7 quad_perm:[1,0,3,2] row_mask:0xf bank_mask:0xf
    s_nop 1
    v_add_f32_dpp v7, v7, v7 quad_perm:[2,3,0,1] row_mask:0xf bank_mask:0xf
    s_nop 0
    v_mov_b32 v8, v7
    s_nop 1
    v_permlane16_swap_b32 v8, v7
    s_nop 1
    v_add_f32 v7, v7, v8
    s_nop 0
    v_mov_b32 v8, v7
    s_nop 1
    v_permlane32_swap_b32 v8, v7
    s_nop 1
    v_add_f32 v7, v7, v8
    v_and_b32 v8, 12, v1
    v_lshlrev_b32 v8, 1, v8
    s_lshl_b32 s57, s20, 5
    v_add_u32 v9, s57, v8
    s_mov_b64 exec, 0x1111
    ds_write_b64 v9, v[6:7] offset:32768
    s_cmp_lg_u32 s20, 0
    s_cbranch_scc1 L_notree
    ds_write_b64 v8, v[16:17] offset:32896
L_notree:
    s_mov_b64 exec, -1
    v_lshrrev_b32 v8, 4, v1
    v_lshlrev_b32 v8, 3, v8
    v_add_u32 v9, s57, v8
    s_waitcnt lgkmcnt(0)
    s_barrier
    ds_read_b64 v[70:71], v8 offset:32768
    ds_read_b64 v[72:73], v8 offset:32800
    ds_read_b64 v[74:75], v8 offset:32832
    ds_read_b64 v[76:77], v8 offset:32864
    ds_read_b64 v[78:79], v8 offset:32896
    ds_read_b32 v68, v9 offset:32768
    v_lshlrev_b32 v60, 16, v20
    v_and_b32 v61, 0xffff0000, v20
    v_lshlrev_b32 v62, 16, v21
    v_and_b32 v63, 0xffff0000, v21
    v_lshlrev_b32 v64, 16, v22
    v_and_b32 v65, 0xffff0000, v22
    v_lshlrev_b32 v66, 16, v23
    v_and_b32 v67, 0xffff0000, v23
    s_waitcnt lgkmcnt(0)
    v_max_f32 v10, v70, v72
    v_max_f32 v10, v10, v74
    v_max_f32 v10, v10, v76
    v_max_f32 v10, v10, v78
    v_sub_f32 v70, v70, v10
    v_sub_f32 v72, v72, v10
    v_sub_f32 v74, v74, v10
    v_sub_f32 v76, v76, v10
    v_sub_f32 v78, v78, v10
    v_sub_f32 v68, v68, v10
    v_exp_f32 v70, v70
    v_exp_f32 v72, v72
    v_exp_f32 v74, v74
    v_exp_f32 v76, v76
    v_exp_f32 v78, v78
    v_exp_f32 v68, v68
    v_mul_f32 v11, v70, v71
    v_fmac_f32 v11, v72, v73
    v_fmac_f32 v11, v74, v75
    v_fmac_f32 v11, v76, v77
    v_fmac_f32 v11, v78, v79
    v_rcp_f32 v11, v11
    s_cmp_eq_u32 s20, 0
    s_cselect_b32 s57, 1.0, 0
    v_mul_f32 v68, v68, v11
    v_mul_f32 v11, v78, v11
    v_mul_f32 v11, s57, v11
    v_mul_f32 v60, v11, v60
    v_mul_f32 v61, v11, v61
    v_mul_f32 v62, v11, v62
    v_mul_f32 v63, v11, v63
    v_mul_f32 v64, v11, v64
    v_mul_f32 v65, v11, v65
    v_mul_f32 v66, v11, v66
    v_mul_f32 v67, v11, v67
    s_lshl_b32 s57, s20, 11
    v_lshlrev_b32 v10, 5, v1
    v_add_u32 v10, s57, v10
    s_lshl_b32 s57, s20, 9
    v_lshlrev_b32 v11, 3, v1
    v_add_u32 v11, s57, v11
    v_lshrrev_b32 v52, 1, v11
    v_and_b32_dpp v24, v56, v4 quad_perm:[0,0,0,0] row_mask:0xf bank_mask:0xf
    v_and_b32_dpp v25, v56, v5 quad_perm:[0,0,0,0] row_mask:0xf bank_mask:0xf
    s_waitcnt vmcnt(7)
    s_nop 0
    v_mfma_f32_16x16x16_bf16 v[28:31], v[24:25], v[80:81], v[28:31]
    v_mfma_f32_16x16x16_bf16 v[32:35], v[24:25], v[82:83], v[32:35]
    v_and_b32_dpp v26, v56, v4 quad_perm:[1,1,1,1] row_mask:0xf bank_mask:0xf
    v_and_b32_dpp v27, v56, v5 quad_perm:[1,1,1,1] row_mask:0xf bank_mask:0xf
    s_waitcnt vmcnt(6)
    s_nop 0
    v_mfma_f32_16x16x16_bf16 v[28:31], v[26:27], v[84:85], v[28:31]
    v_mfma_f32_16x16x16_bf16 v[32:35], v[26:27], v[86:87], v[32:35]
    v_and_b32_dpp v24, v56, v4 quad_perm:[2,2,2,2] row_mask:0xf bank_mask:0xf
    v_and_b32_dpp v25, v56, v5 quad_perm:[2,2,2,2] row_mask:0xf bank_mask:0xf
    s_waitcnt vmcnt(5)
    s_nop 0
    v_mfma_f32_16x16x16_bf16 v[28:31], v[24:25], v[88:89], v[28:31]
    v_mfma_f32_16x16x16_bf16 v[32:35], v[24:25], v[90:91], v[32:35]
    v_and_b32_dpp v26, v56, v4 quad_perm:[3,3,3,3] row_mask:0xf bank_mask:0xf
    v_and_b32_dpp v27, v56, v5 quad_perm:[3,3,3,3] row_mask:0xf bank_mask:0xf
    s_waitcnt vmcnt(4)
    s_nop 0
    v_mfma_f32_16x16x16_bf16 v[28:31], v[26:27], v[92:93], v[28:31]
    v_mfma_f32_16x16x16_bf16 v[32:35], v[26:27], v[94:95], v[32:35]
    v_and_b32_dpp v24, v57, v4 quad_perm:[0,0,0,0] row_mask:0xf bank_mask:0xf
    v_and_b32_dpp v25, v57, v5 quad_perm:[0,0,0,0] row_mask:0xf bank_mask:0xf
    s_waitcnt vmcnt(3)
    s_nop 0
    v_mfma_f32_16x16x16_bf16 v[28:31], v[24:25], v[96:97], v[28:31]
    v_mfma_f32_16x16x16_bf16 v[32:35], v[24:25], v[98:99], v[32:35]
    v_and_b32_dpp v26, v57, v4 quad_perm:[1,1,1,1] row_mask:0xf bank_mask:0xf
    v_and_b32_dpp v27, v57, v5 quad_perm:[1,1,1,1] row_mask:0xf bank_mask:0xf
    s_waitcnt vmcnt(2)
    s_nop 0
    v_mfma_f32_16x16x16_bf16 v[28:31], v[26:27], v[100:101], v[28:31]
    v_mfma_f32_16x16x16_bf16 v[32:35], v[26:27], v[102:103], v[32:35]
    v_and_b32_dpp v24, v57, v4 quad_perm:[2,2,2,2] row_mask:0xf bank_mask:0xf
    v_and_b32_dpp v25, v57, v5 quad_perm:[2,2,2,2] row_mask:0xf bank_mask:0xf
    s_waitcnt vmcnt(1)
    s_nop 0
    v_mfma_f32_16x16x16_bf16 v[28:31], v[24:25], v[104:105], v[28:31]
    v_mfma_f32_16x16x16_bf16 v[32:35], v[24:25], v[106:107], v[32:35]
    v_and_b32_dpp v26, v57, v4 quad_perm:[3,3,3,3] row_mask:0xf bank_mask:0xf
    v_and_b32_dpp v27, v57, v5 quad_perm:[3,3,3,3] row_mask:0xf bank_mask:0xf
    s_waitcnt vmcnt(0)
    s_nop 0
    v_mfma_f32_16x16x16_bf16 v[28:31], v[26:27], v[108:109], v[28:31]
    v_mfma_f32_16x16x16_bf16 v[32:35], v[26:27], v[110:111], v[32:35]
    s_nop 6
    v_fma_f32 v28, v28, v68, v60
    v_fma_f32 v29, v29, v68, v61
    v_fma_f32 v30, v30, v68, v62
    v_fma_f32 v31, v31, v68, v63
    ds_write_b128 v10, v[28:31] offset:33024
    v_fma_f32 v32, v32, v68, v64
    v_fma_f32 v33, v33, v68, v65
    v_fma_f32 v34, v34, v68, v66
    v_fma_f32 v35, v35, v68, v67
    ds_write_b128 v10, v[32:35] offset:33040
    s_waitcnt lgkmcnt(0)
    s_barrier
    ds_read_b64 v[36:37], v11 offset:33024
    ds_read_b64 v[38:39], v11 offset:35072
    ds_read_b64 v[40:41], v11 offset:37120
    ds_read_b64 v[42:43], v11 offset:39168
    s_waitcnt lgkmcnt(2)
    v_add_f32 v36, v36, v38
    v_add_f32 v37, v37, v39
    s_waitcnt lgkmcnt(0)
    v_add_f32 v40, v40, v42
    v_add_f32 v41, v41, v43
    v_add_f32 v36, v36, v40
    v_add_f32 v37, v37, v41
    v_cvt_pk_bf16_f32 v36, v36, v37
    buffer_store_dword v36, v52, s[52:55], 0 offen
L_end:
    s_endpgm
L_helper:
    s_waitcnt lgkmcnt(0)
    s_load_dwordx2 s[4:5], s[0:1], 64
    v_lshlrev_b32 v2, 2, v1
    v_mov_b32 v3, 0
    v_mov_b32 v4, -1
    ds_write_b32 v2, v3 offset:41216
    ds_write_b32 v3, v4 offset:41472
    s_getreg_b32 s16, hwreg(HW_REG_XCC_ID, 0, 3)
    s_lshl_b32 s16, s16, 13
    s_add_u32 s16, s16, 0x400000
    s_waitcnt lgkmcnt(0)
    s_barrier
    s_add_u32 s8, s4, s16
    s_addc_u32 s9, s5, 0
    s_mov_b32 s10, 8192
    s_mov_b32 s11, 0x20000
    s_add_u32 s24, s4, 0x420000
    s_addc_u32 s25, s5, 0
    s_mov_b32 s26, 0x8000
    s_mov_b32 s27, 0x20000
    v_and_b32 v14, 7, v1
    v_lshlrev_b32 v14, 7, v14
    s_and_b32 s16, s2, 7
    s_lshl_b32 s16, s16, 7
    v_mov_b32 v15, s16
    s_mov_b32 s28, 0
    s_mov_b32 s21, 0
    s_mov_b32 s23, 0
    s_mov_b32 s29, 0
    s_mov_b32 s30, 0
    s_mov_b32 s31, 0
    s_mov_b32 s19, 0
    s_mov_b32 s12, 0
    s_mov_b32 s14, 0
    v_and_b32 v5, 60, v2
    s_lshr_b32 s16, s2, 3
    s_lshl_b32 s16, s16, 2
    v_mov_b32 v6, s16
    s_mov_b32 s15, 20000
L_h_next:
    s_lshl_b32 s16, s12, 2
    v_mov_b32 v7, s16
L_h_w1:
    ds_read_b32 v8, v7 offset:41216
    s_sub_u32 s15, s15, 1
    s_cbranch_scc1 L_end
    s_waitcnt lgkmcnt(0)
    v_readfirstlane_b32 s13, v8
    s_nop 0
    s_cmp_lg_u32 s13, 0
    s_cbranch_scc1 L_h_pub
    s_sleep 8
    s_branch L_h_w1
L_h_pub:
    s_cmp_ge_u32 s2, 128
    s_cbranch_scc1 L_h_w2
    s_cmp_ge_u32 s2, 8
    s_cbranch_scc1 L_h_st
    s_cmp_eq_u32 s29, 0
    s_cbranch_scc1 L_h_adj
    buffer_load_dword v9, v14, s[24:27], s29 offen sc1
    s_waitcnt vmcnt(0)
    v_subrev_u32 v9, s31, v9
    v_add_u32 v11, 1000, v9
    v_cmp_gt_u32 vcc, 2000, v11
    s_nop 1
    v_cndmask_b32 v9, 35, v9, vcc
    s_nop 1
    v_add_u32_dpp v9, v9, v9 quad_perm:[1,0,3,2] row_mask:0xf bank_mask:0xf
    s_nop 1
    v_add_u32_dpp v9, v9, v9 quad_perm:[2,3,0,1] row_mask:0xf bank_mask:0xf
    s_nop 1
    v_add_u32_dpp v9, v9, v9 row_half_mirror row_mask:0xf bank_mask:0xf
    s_cmp_eq_u64 vcc, exec
    s_cselect_b32 s29, 0, s29
    v_readfirstlane_b32 s16, v9
    s_nop 0
    s_mul_i32 s16, s16, -2
    s_sub_i32 s21, s16, s23
L_h_adj:
    s_mul_i32 s16, s21, 10
    s_ashr_i32 s16, s16, 3
    s_min_i32 s16, s16, 480
    s_max_i32 s28, s16, -480
    s_sub_i32 s16, s28, 80
    s_max_i32 s16, s16, 0
    s_add_i32 s17, s28, 240
    s_min_i32 s17, s17, 0
    s_add_i32 s16, s16, s17
    s_mul_i32 s16, s16, 5
    s_ashr_i32 s16, s16, 5
    s_sub_i32 s21, s21, s16
    s_add_i32 s23, s23, s16
    v_subrev_u32 v8, s28, v8
L_h_st:
    s_mov_b64 exec, 1
    buffer_store_dword v8, v6, s[8:11], s14 offen
    s_mov_b64 exec, -1
L_h_w2:
    buffer_load_dword v9, v5, s[8:11], s14 offen sc1
    ds_read_b32 v10, v7 offset:41224
    s_sub_u32 s15, s15, 1
    s_cbranch_scc1 L_end
    s_waitcnt vmcnt(0) lgkmcnt(0)
    v_subrev_u32 v9, s13, v9
    v_readfirstlane_b32 s18, v10
    v_add_u32 v11, 2000, v9
    v_cmp_gt_u32 vcc, 4000, v11
    s_nop 1
    s_cmp_eq_u64 vcc, exec
    s_cbranch_scc1 L_h_sum
    s_cmp_lg_u32 s18, 0
    s_cbranch_scc1 L_h_fill
    s_sleep 8
    s_branch L_h_w2
L_h_fill:
    v_cndmask_b32 v9, 0, v9, vcc
L_h_sum:
    s_nop 1
    v_add_u32_dpp v9, v9, v9 quad_perm:[1,0,3,2] row_mask:0xf bank_mask:0xf
    s_nop 1
    v_add_u32_dpp v9, v9, v9 quad_perm:[2,3,0,1] row_mask:0xf bank_mask:0xf
    s_nop 1
    v_add_u32_dpp v9, v9, v9 row_half_mirror row_mask:0xf bank_mask:0xf
    s_nop 1
    v_add_u32_dpp v9, v9, v9 row_mirror row_mask:0xf bank_mask:0xf
    v_mov_b32 v12, s12
    v_ashrrev_i32 v9, 4, v9
    v_add_u32 v13, s13, v9
    ds_write_b64 v3, v[12:13] offset:41472
    s_cmp_ge_u32 s2, 8
    s_cbranch_scc1 L_h_adv
    s_cmp_lg_u32 s19, s12
    s_cbranch_scc1 L_h_adv
    s_add_u32 s19, s19, 6
    s_mov_b32 s23, 0
    s_ashr_i32 s16, s28, 4
    v_add_u32 v16, s16, v13
    s_add_u32 s30, s30, 1024
    s_mov_b32 s29, s30
    v_readfirstlane_b32 s31, v16
    s_mov_b64 exec, 1
    buffer_store_dword v16, v15, s[24:27], s29 offen sc0 sc1
    s_mov_b64 exec, -1
L_h_adv:
    s_add_u32 s12, s12, 2
    s_add_u32 s14, s14, 128
    s_cmp_le_u32 s12, 24
    s_cbranch_scc1 L_h_next
    s_endpgm
.section .rodata,"a"
.p2align 6
.amdhsa_kernel standalone__tree_speculative_verify_tree_attention_over_candidate_token_tree__sampling_kernel
  .amdhsa_next_free_vgpr 112
  .amdhsa_next_free_sgpr 66
  .amdhsa_accum_offset 112
  .amdhsa_group_segment_fixed_size 0
  .amdhsa_kernarg_size 72
  .amdhsa_user_sgpr_count 2
  .amdhsa_user_sgpr_kernarg_segment_ptr 1
  .amdhsa_system_sgpr_workgroup_id_x 1
.end_amdhsa_kernel
```
